```python
import torch

def _softmax(x, axis=-1):
    return torch.softmax(x, dim=axis)

def _gelu(x):
    return torch.nn.functional.gelu(x, approximate='tanh')

def _silu(x):
    return torch.nn.functional.silu(x)

def _sigmoid(x):
    return torch.sigmoid(x)

def _layernorm(x, axis=-1, eps=1e-05):
    m = x.mean(dim=axis, keepdim=True)
    v = x.var(dim=axis, keepdim=True, unbiased=False)
    return (x - m) / torch.sqrt(v + eps)

def _scatter_add(tgt, idx, src, axis=0):
    return tgt.clone().index_add_(axis, idx, src)

def _segment_sum(src, seg, n):
    out = torch.zeros((n,) + src.shape[1:], dtype=src.dtype)
    return out.index_add_(0, seg, src)

def _pad(x, pw):
    flat = tuple((v for pair in reversed(pw) for v in pair))
    return torch.nn.functional.pad(x, flat)
kernel_name = 'standalone__tree_speculative_verify_tree_attention_over_candidate_token_tree__sampling'

def setup_inputs():

    _w = lambda a: (lambda t: t.to(torch.bfloat16) if t.is_floating_point() else t)(torch.as_tensor(a))
    B, Hq, Hkv, T, C, D = (8, 32, 32, 16, 4096, 128)
    tree_mask = torch.zeros((B, T, T), dtype=float)
    for b in range(B):
        parent = torch.zeros(T, dtype=torch.int64)
        for i in range(1, T):
            parent[i] = int(torch.randint(0, i, (1,)).item())
        for i in range(T):
            j = i
            tree_mask[b, i, j] = 1.0
            while j > 0:
                j = parent[j]
                tree_mask[b, i, j] = 1.0
    return {'q': _w((lambda *s: torch.randn(*s, dtype=torch.bfloat16) * 0.8)(B, Hq, T, D)), 'k_cache': _w((lambda *s: torch.randn(*s, dtype=torch.bfloat16) * 0.8)(B, Hkv, C, D)), 'v_cache': _w((lambda *s: torch.randn(*s, dtype=torch.bfloat16) * 0.05)(B, Hkv, C, D)), 'k_tree': _w((lambda *s: torch.randn(*s, dtype=torch.bfloat16) * 0.8)(B, Hkv, T, D)), 'v_tree': _w((lambda *s: torch.randn(*s, dtype=torch.bfloat16) * 0.05)(B, Hkv, T, D)), 'tree_mask': _w(tree_mask)}

def reference(q, k_cache, v_cache, k_tree, v_tree, tree_mask):
    B, Hq, T, D = q.shape
    Hkv, C = (k_cache.shape[1], k_cache.shape[2])
    rep = Hq // Hkv
    kc = (lambda x, n, axis: torch.repeat_interleave(x, n, dim=axis))(k_cache, rep, axis=1)
    vc = (lambda x, n, axis: torch.repeat_interleave(x, n, dim=axis))(v_cache, rep, axis=1)
    kt = (lambda x, n, axis: torch.repeat_interleave(x, n, dim=axis))(k_tree, rep, axis=1)
    vt = (lambda x, n, axis: torch.repeat_interleave(x, n, dim=axis))(v_tree, rep, axis=1)
    k = torch.concatenate([kc, kt], axis=2)
    v = torch.concatenate([vc, vt], axis=2)
    scale = D ** (-0.5)
    scores = torch.einsum('bhqd,bhkd->bhqk', q, k) * scale
    ctx_mask = torch.ones((B, 1, T, C), dtype=scores.dtype)
    tm = tree_mask[:, None, :, :].clone()
    full_mask = torch.concatenate([ctx_mask, tm], axis=-1)
    scores = scores + (1.0 - full_mask) * -1000000000.0
    p = _softmax(scores, axis=-1)
    return torch.einsum('bhqk,bhkd->bhqd', p, v)
```

```asm
; @launch grid=(256,1,1) block=(256,1,1) lds=160064
.amdgcn_target "amdgcn-amd-amdhsa--gfx950"
.text
.globl standalone__tree_speculative_verify_tree_attention_over_candidate_token_tree__sampling_kernel
.p2align 8
.type standalone__tree_speculative_verify_tree_attention_over_candidate_token_tree__sampling_kernel,@function
standalone__tree_speculative_verify_tree_attention_over_candidate_token_tree__sampling_kernel:
  s_cmp_ge_u32 s2, 256
  s_cbranch_scc1 L_end
  s_load_dwordx4 s[4:7], s[0:1], 0
  s_load_dwordx4 s[8:11], s[0:1], 16
  s_load_dwordx4 s[12:15], s[0:1], 32
  s_load_dwordx4 s[16:19], s[0:1], 48
  s_load_dwordx2 s[86:87], s[0:1], 64
  v_lshrrev_b32 v97, 6, v0
  v_mov_b32 v14, 159744
  v_readfirstlane_b32 s48, v97
  s_getpc_b64 s[40:41]
L_pc0:
  s_cmp_lg_u32 s48, 3
  s_cbranch_scc1 L_nopf
  s_lshr_b32 s42, s2, 3
  s_mul_i32 s42, s42, 384
  s_min_u32 s42, s42, L_codeend-L_pc0-384
  s_add_u32 s40, s40, s42
  s_addc_u32 s41, s41, 0
  s_load_dword s44, s[40:41], 0
  s_load_dword s45, s[40:41], 128
  s_load_dword s46, s[40:41], 256
  s_branch L_control
L_nopf:
  s_bfe_u32 s3, s2, 65536
  s_lshl_b32 s3, s3, 5
  s_bfe_u32 s55, s2, 65537
  s_lshl_b32 s55, s55, 1
  s_or_b32 s3, s3, s55
  s_bfe_u32 s55, s2, 65538
  s_lshl_b32 s55, s55, 7
  s_or_b32 s3, s3, s55
  s_bfe_u32 s55, s2, 65539
  s_lshl_b32 s55, s55, 0
  s_or_b32 s3, s3, s55
  s_bfe_u32 s55, s2, 65540
  s_lshl_b32 s55, s55, 6
  s_or_b32 s3, s3, s55
  s_bfe_u32 s55, s2, 196613
  s_lshl_b32 s55, s55, 2
  s_or_b32 s3, s3, s55
  v_lshrrev_b32 v97, 6, v0
  v_and_b32 v1, 63, v0
  v_readfirstlane_b32 s48, v97
  v_lshrrev_b32 v100, 4, v1
  v_and_b32 v101, 15, v1
  v_lshlrev_b32 v97, 1, v100
  v_xor_b32 v97, v97, v101
  v_lshlrev_b32 v97, 4, v97
  v_lshl_add_u32 v2, v100, 8, v97
  v_xor_b32 v3, 0x80, v2
  v_mov_b32 v14, 159744
  v_mov_b32 v114, 0
  s_lshl_b32 s55, s3, 20
  s_cmp_lg_u32 s48, 0
  s_cbranch_scc1 L_consumer
  s_setprio 3
  v_and_b32 v98, 0xff, v2
  v_and_b32 v97, 1, v100
  v_lshl_add_u32 v98, v97, 10, v98
  v_lshrrev_b32 v97, 1, v100
  v_lshl_add_u32 v98, v97, 15, v98
  v_xor_b32 v99, 0x80, v98
  v_add_u32 v4, 4096, v98
  v_add_u32 v5, 3584, v99
  v_add_u32 v6, 4096, v98
  v_add_u32 v7, 3584, v99
  v_add_u32 v8, 4352, v98
  v_add_u32 v9, 3840, v99
  v_add_u32 v10, 4352, v98
  v_add_u32 v11, 3840, v99
  s_mov_b32 s51, 0
  s_bfe_u32 s92, s2, 65541
  s_lshl_b32 s92, s92, 17
  s_xor_b32 s51, s51, s92
  s_bfe_u32 s92, s2, 65542
  s_lshl_b32 s92, s92, 13
  s_xor_b32 s51, s51, s92
  s_bfe_u32 s92, s2, 65543
  s_lshl_b32 s92, s92, 14
  s_xor_b32 s51, s51, s92
  s_bfe_u32 s92, s2, 65537
  s_lshl_b32 s92, s92, 13
  s_xor_b32 s51, s51, s92
  s_bfe_u32 s92, s2, 65539
  s_lshl_b32 s92, s92, 14
  s_xor_b32 s51, s51, s92
  s_bfe_u32 s92, s2, 65538
  s_lshl_b32 s92, s92, 13
  s_xor_b32 s51, s51, s92
  s_sub_u32 s55, s55, 4096
  s_mov_b32 s22, 1052672
  s_mov_b32 s23, 0x20000
  s_mov_b32 s49, 0
  s_mov_b32 s50, 0
  v_mov_b32 v116, -1
  v_mov_b32 v117, 0
  v_mov_b32 v118, 21
  v_mov_b32 v119, 0
  ds_write_b32 v14, v117
  ds_write_b128 v14, v[116:119] offset:16
  ds_write2_b32 v14, v117, v117 offset0:8 offset1:9
  s_waitcnt lgkmcnt(0)
  s_ashr_i32 s92, s55, 31
  s_add_u32 s20, s6, s55
  s_addc_u32 s21, s7, s92
  s_add_u32 s24, s8, s55
  s_addc_u32 s25, s9, s92
  s_add_u32 m0, s49, 0
  s_xor_b32 s55, s51, 0
  buffer_load_dwordx4 v4, s[20:23], s55 offen offset:0 nt lds
  buffer_load_dwordx4 v5, s[20:23], s55 offen offset:1024 nt lds
  buffer_load_dwordx4 v6, s[20:23], s55 offen offset:2048 nt lds
  buffer_load_dwordx4 v7, s[20:23], s55 offen offset:3072 nt lds
  s_add_u32 m0, s49, 4096
  s_nop 0
  buffer_load_dwordx4 v8, s[20:23], s55 offen offset:0 nt lds
  buffer_load_dwordx4 v9, s[20:23], s55 offen offset:1024 nt lds
  buffer_load_dwordx4 v10, s[20:23], s55 offen offset:2048 nt lds
  buffer_load_dwordx4 v11, s[20:23], s55 offen offset:3072 nt lds
  s_add_u32 s50, s50, 0x2000
  s_add_u32 s49, s49, 0x2000
  s_cmp_lt_u32 s49, 90112
  s_cselect_b32 s49, s49, 0
  s_add_u32 m0, s49, 0
  s_xor_b32 s55, s51, 8192
  buffer_load_dwordx4 v4, s[20:23], s55 offen offset:0 nt lds
  buffer_load_dwordx4 v5, s[20:23], s55 offen offset:1024 nt lds
  buffer_load_dwordx4 v6, s[20:23], s55 offen offset:2048 nt lds
  buffer_load_dwordx4 v7, s[20:23], s55 offen offset:3072 nt lds
  s_add_u32 m0, s49, 4096
  s_nop 0
  buffer_load_dwordx4 v8, s[20:23], s55 offen offset:0 nt lds
  buffer_load_dwordx4 v9, s[20:23], s55 offen offset:1024 nt lds
  buffer_load_dwordx4 v10, s[20:23], s55 offen offset:2048 nt lds
  buffer_load_dwordx4 v11, s[20:23], s55 offen offset:3072 nt lds
  s_add_u32 s50, s50, 0x2000
  s_add_u32 s49, s49, 0x2000
  s_cmp_lt_u32 s49, 90112
  s_cselect_b32 s49, s49, 0
  s_add_u32 m0, s49, 0
  s_xor_b32 s55, s51, 16384
  buffer_load_dwordx4 v4, s[20:23], s55 offen offset:0 nt lds
  buffer_load_dwordx4 v5, s[20:23], s55 offen offset:1024 nt lds
  buffer_load_dwordx4 v6, s[20:23], s55 offen offset:2048 nt lds
  buffer_load_dwordx4 v7, s[20:23], s55 offen offset:3072 nt lds
  s_add_u32 m0, s49, 4096
  s_nop 0
  buffer_load_dwordx4 v8, s[20:23], s55 offen offset:0 nt lds
  buffer_load_dwordx4 v9, s[20:23], s55 offen offset:1024 nt lds
  buffer_load_dwordx4 v10, s[20:23], s55 offen offset:2048 nt lds
  buffer_load_dwordx4 v11, s[20:23], s55 offen offset:3072 nt lds
  s_add_u32 s50, s50, 0x2000
  s_add_u32 s49, s49, 0x2000
  s_cmp_lt_u32 s49, 90112
  s_cselect_b32 s49, s49, 0
  s_add_u32 m0, s49, 0
  s_xor_b32 s55, s51, 24576
  buffer_load_dwordx4 v4, s[20:23], s55 offen offset:0 nt lds
  buffer_load_dwordx4 v5, s[20:23], s55 offen offset:1024 nt lds
  buffer_load_dwordx4 v6, s[20:23], s55 offen offset:2048 nt lds
  buffer_load_dwordx4 v7, s[20:23], s55 offen offset:3072 nt lds
  s_add_u32 m0, s49, 4096
  s_nop 0
  s_barrier
  s_waitcnt vmcnt(27)
  buffer_load_dwordx4 v8, s[20:23], s55 offen offset:0 nt lds
  s_waitcnt vmcnt(27)
  buffer_load_dwordx4 v9, s[20:23], s55 offen offset:1024 nt lds
  s_waitcnt vmcnt(27)
  buffer_load_dwordx4 v10, s[20:23], s55 offen offset:2048 nt lds
  s_waitcnt vmcnt(27)
  buffer_load_dwordx4 v11, s[20:23], s55 offen offset:3072 nt lds
  ds_read_b128 v[116:119], v14 offset:16
  s_add_u32 s50, s50, 0x2000
  s_add_u32 s49, s49, 0x2000
  s_cmp_lt_u32 s49, 90112
  s_cselect_b32 s49, s49, 0
  s_mov_b32 s95, 4
  s_mov_b32 s97, 124
  s_mov_b32 s96, 0
L_ldtop:
  v_mov_b32 v105, s95
  s_cmp_lg_u32 s97, 0
  s_cbranch_scc1 L_ldnsw
  s_mov_b64 s[98:99], s[20:21]
  s_mov_b64 s[20:21], s[24:25]
  s_mov_b64 s[24:25], s[98:99]
  s_mov_b32 s97, 128
  s_xor_b32 s96, s96, 1
  s_cselect_b32 s55, 1048576, 0
  s_sub_u32 s50, s50, s55
L_ldnsw:
  s_sub_u32 s59, s95, 11
L_ldchk:
  s_waitcnt lgkmcnt(0)
  v_readfirstlane_b32 s92, v116
  v_readfirstlane_b32 s93, v117
  v_readfirstlane_b32 s94, v118
  s_min_i32 s92, s92, s93
  s_cmp_ge_i32 s92, s59
  s_cbranch_scc0 L_ldslow
  s_sub_u32 s97, s97, 1
  s_and_b32 s55, s50, 24576
  s_bfe_u32 s92, s50, 262159
  s_lshl_b32 s92, s92, 16
  s_or_b32 s55, s55, s92
  s_bfe_u32 s92, s50, 65555
  s_lshl_b32 s92, s92, 12
  s_or_b32 s55, s55, s92
  s_xor_b32 s55, s55, s51
  s_cmp_ge_u32 s94, 25
  s_cbranch_scc1 L_dsp1
  s_cmp_ge_u32 s94, 21
  s_cbranch_scc1 L_dsp2
  s_cmp_ge_u32 s94, 19
  s_cbranch_scc1 L_dsp3
  s_branch L_ldv0
L_dsp3:
  s_cmp_ge_u32 s94, 20
  s_cbranch_scc1 L_ldv2
  s_branch L_ldv1
L_dsp2:
  s_cmp_ge_u32 s94, 23
  s_cbranch_scc1 L_dsp4
  s_cmp_ge_u32 s94, 22
  s_cbranch_scc1 L_ldv4
  s_branch L_ldv3
L_dsp4:
  s_cmp_ge_u32 s94, 24
  s_cbranch_scc1 L_ldv6
  s_branch L_ldv5
L_dsp1:
  s_cmp_ge_u32 s94, 28
  s_cbranch_scc1 L_dsp5
  s_cmp_ge_u32 s94, 26
  s_cbranch_scc1 L_dsp6
  s_branch L_ldv7
L_dsp6:
  s_cmp_ge_u32 s94, 27
  s_cbranch_scc1 L_ldv9
  s_branch L_ldv8
L_dsp5:
  s_cmp_ge_u32 s94, 32
  s_cbranch_scc1 L_dsp7
  s_cmp_ge_u32 s94, 30
  s_cbranch_scc1 L_ldv11
  s_branch L_ldv10
L_dsp7:
  s_cmp_ge_u32 s94, 36
  s_cbranch_scc1 L_ldv13
  s_branch L_ldv12
L_ldv0:
  s_add_u32 m0, s49, 0
  s_waitcnt vmcnt(17)
  buffer_load_dwordx4 v4, s[20:23], s55 offen offset:0 nt lds
  s_waitcnt vmcnt(17)
  buffer_load_dwordx4 v5, s[20:23], s55 offen offset:1024 nt lds
  v_add_u32 v104, -2, v105
  ds_write_b32 v14, v104
  s_waitcnt vmcnt(17)
  buffer_load_dwordx4 v6, s[20:23], s55 offen offset:2048 nt lds
  s_waitcnt vmcnt(17)
  buffer_load_dwordx4 v7, s[20:23], s55 offen offset:3072 nt lds
  s_add_u32 m0, s49, 4096
  s_waitcnt vmcnt(17)
  buffer_load_dwordx4 v8, s[20:23], s55 offen offset:0 nt lds
  ds_read_b128 v[116:119], v14 offset:16
  s_waitcnt vmcnt(17)
  buffer_load_dwordx4 v9, s[20:23], s55 offen offset:1024 nt lds
  s_waitcnt vmcnt(17)
  buffer_load_dwordx4 v10, s[20:23], s55 offen offset:2048 nt lds
  s_waitcnt vmcnt(17)
  buffer_load_dwordx4 v11, s[20:23], s55 offen offset:3072 nt lds
  s_add_u32 s50, s50, 0x2000
  s_add_u32 s49, s49, 0x2000
  s_cmp_lt_u32 s49, 90112
  s_cselect_b32 s49, s49, 0
  s_add_u32 s95, s95, 1
  s_cmp_lt_u32 s95, 256
  s_cbranch_scc1 L_ldtop
  s_branch L_ldtail
L_ldv1:
  s_add_u32 m0, s49, 0
  s_waitcnt vmcnt(18)
  buffer_load_dwordx4 v4, s[20:23], s55 offen offset:0 nt lds
  s_waitcnt vmcnt(18)
  buffer_load_dwordx4 v5, s[20:23], s55 offen offset:1024 nt lds
  s_waitcnt vmcnt(18)
  buffer_load_dwordx4 v6, s[20:23], s55 offen offset:2048 nt lds
  v_add_u32 v104, -2, v105
  ds_write_b32 v14, v104
  s_waitcnt vmcnt(18)
  buffer_load_dwordx4 v7, s[20:23], s55 offen offset:3072 nt lds
  s_add_u32 m0, s49, 4096
  s_waitcnt vmcnt(18)
  buffer_load_dwordx4 v8, s[20:23], s55 offen offset:0 nt lds
  ds_read_b128 v[116:119], v14 offset:16
  s_waitcnt vmcnt(18)
  buffer_load_dwordx4 v9, s[20:23], s55 offen offset:1024 nt lds
  s_waitcnt vmcnt(18)
  buffer_load_dwordx4 v10, s[20:23], s55 offen offset:2048 nt lds
  s_waitcnt vmcnt(18)
  buffer_load_dwordx4 v11, s[20:23], s55 offen offset:3072 nt lds
  s_add_u32 s50, s50, 0x2000
  s_add_u32 s49, s49, 0x2000
  s_cmp_lt_u32 s49, 90112
  s_cselect_b32 s49, s49, 0
  s_add_u32 s95, s95, 1
  s_cmp_lt_u32 s95, 256
  s_cbranch_scc1 L_ldtop
  s_branch L_ldtail
L_ldv2:
  s_add_u32 m0, s49, 0
  s_waitcnt vmcnt(19)
  buffer_load_dwordx4 v4, s[20:23], s55 offen offset:0 nt lds
  s_waitcnt vmcnt(19)
  buffer_load_dwordx4 v5, s[20:23], s55 offen offset:1024 nt lds
  s_waitcnt vmcnt(19)
  buffer_load_dwordx4 v6, s[20:23], s55 offen offset:2048 nt lds
  s_waitcnt vmcnt(19)
  buffer_load_dwordx4 v7, s[20:23], s55 offen offset:3072 nt lds
  v_add_u32 v104, -2, v105
  ds_write_b32 v14, v104
  s_add_u32 m0, s49, 4096
  s_waitcnt vmcnt(19)
  buffer_load_dwordx4 v8, s[20:23], s55 offen offset:0 nt lds
  ds_read_b128 v[116:119], v14 offset:16
  s_waitcnt vmcnt(19)
  buffer_load_dwordx4 v9, s[20:23], s55 offen offset:1024 nt lds
  s_waitcnt vmcnt(19)
  buffer_load_dwordx4 v10, s[20:23], s55 offen offset:2048 nt lds
  s_waitcnt vmcnt(19)
  buffer_load_dwordx4 v11, s[20:23], s55 offen offset:3072 nt lds
  s_add_u32 s50, s50, 0x2000
  s_add_u32 s49, s49, 0x2000
  s_cmp_lt_u32 s49, 90112
  s_cselect_b32 s49, s49, 0
  s_add_u32 s95, s95, 1
  s_cmp_lt_u32 s95, 256
  s_cbranch_scc1 L_ldtop
  s_branch L_ldtail
L_ldv3:
  s_add_u32 m0, s49, 0
  s_waitcnt vmcnt(20)
  buffer_load_dwordx4 v4, s[20:23], s55 offen offset:0 nt lds
  s_waitcnt vmcnt(20)
  buffer_load_dwordx4 v5, s[20:23], s55 offen offset:1024 nt lds
  s_waitcnt vmcnt(20)
  buffer_load_dwordx4 v6, s[20:23], s55 offen offset:2048 nt lds
  s_waitcnt vmcnt(20)
  buffer_load_dwordx4 v7, s[20:23], s55 offen offset:3072 nt lds
  s_add_u32 m0, s49, 4096
  s_waitcnt vmcnt(20)
  buffer_load_dwordx4 v8, s[20:23], s55 offen offset:0 nt lds
  v_add_u32 v104, -2, v105
  ds_write_b32 v14, v104
  ds_read_b128 v[116:119], v14 offset:16
  s_waitcnt vmcnt(20)
  buffer_load_dwordx4 v9, s[20:23], s55 offen offset:1024 nt lds
  s_waitcnt vmcnt(20)
  buffer_load_dwordx4 v10, s[20:23], s55 offen offset:2048 nt lds
  s_waitcnt vmcnt(20)
  buffer_load_dwordx4 v11, s[20:23], s55 offen offset:3072 nt lds
  s_add_u32 s50, s50, 0x2000
  s_add_u32 s49, s49, 0x2000
  s_cmp_lt_u32 s49, 90112
  s_cselect_b32 s49, s49, 0
  s_add_u32 s95, s95, 1
  s_cmp_lt_u32 s95, 256
  s_cbranch_scc1 L_ldtop
  s_branch L_ldtail
L_ldv4:
  s_add_u32 m0, s49, 0
  s_waitcnt vmcnt(21)
  buffer_load_dwordx4 v4, s[20:23], s55 offen offset:0 nt lds
  s_waitcnt vmcnt(21)
  buffer_load_dwordx4 v5, s[20:23], s55 offen offset:1024 nt lds
  s_waitcnt vmcnt(21)
  buffer_load_dwordx4 v6, s[20:23], s55 offen offset:2048 nt lds
  s_waitcnt vmcnt(21)
  buffer_load_dwordx4 v7, s[20:23], s55 offen offset:3072 nt lds
  s_add_u32 m0, s49, 4096
  s_waitcnt vmcnt(21)
  buffer_load_dwordx4 v8, s[20:23], s55 offen offset:0 nt lds
  ds_read_b128 v[116:119], v14 offset:16
  s_waitcnt vmcnt(21)
  buffer_load_dwordx4 v9, s[20:23], s55 offen offset:1024 nt lds
  v_add_u32 v104, -2, v105
  ds_write_b32 v14, v104
  s_waitcnt vmcnt(21)
  buffer_load_dwordx4 v10, s[20:23], s55 offen offset:2048 nt lds
  s_waitcnt vmcnt(21)
  buffer_load_dwordx4 v11, s[20:23], s55 offen offset:3072 nt lds
  s_add_u32 s50, s50, 0x2000
  s_add_u32 s49, s49, 0x2000
  s_cmp_lt_u32 s49, 90112
  s_cselect_b32 s49, s49, 0
  s_add_u32 s95, s95, 1
  s_cmp_lt_u32 s95, 256
  s_cbranch_scc1 L_ldtop
  s_branch L_ldtail
L_ldv5:
  s_add_u32 m0, s49, 0
  s_waitcnt vmcnt(22)
  buffer_load_dwordx4 v4, s[20:23], s55 offen offset:0 nt lds
  s_waitcnt vmcnt(22)
  buffer_load_dwordx4 v5, s[20:23], s55 offen offset:1024 nt lds
  s_waitcnt vmcnt(22)
  buffer_load_dwordx4 v6, s[20:23], s55 offen offset:2048 nt lds
  s_waitcnt vmcnt(22)
  buffer_load_dwordx4 v7, s[20:23], s55 offen offset:3072 nt lds
  s_add_u32 m0, s49, 4096
  s_waitcnt vmcnt(22)
  buffer_load_dwordx4 v8, s[20:23], s55 offen offset:0 nt lds
  ds_read_b128 v[116:119], v14 offset:16
  s_waitcnt vmcnt(22)
  buffer_load_dwordx4 v9, s[20:23], s55 offen offset:1024 nt lds
  s_waitcnt vmcnt(22)
  buffer_load_dwordx4 v10, s[20:23], s55 offen offset:2048 nt lds
  v_add_u32 v104, -2, v105
  ds_write_b32 v14, v104
  s_waitcnt vmcnt(22)
  buffer_load_dwordx4 v11, s[20:23], s55 offen offset:3072 nt lds
  s_add_u32 s50, s50, 0x2000
  s_add_u32 s49, s49, 0x2000
  s_cmp_lt_u32 s49, 90112
  s_cselect_b32 s49, s49, 0
  s_add_u32 s95, s95, 1
  s_cmp_lt_u32 s95, 256
  s_cbranch_scc1 L_ldtop
  s_branch L_ldtail
L_ldv6:
  s_add_u32 m0, s49, 0
  s_waitcnt vmcnt(23)
  buffer_load_dwordx4 v4, s[20:23], s55 offen offset:0 nt lds
  s_waitcnt vmcnt(23)
  buffer_load_dwordx4 v5, s[20:23], s55 offen offset:1024 nt lds
  s_waitcnt vmcnt(23)
  buffer_load_dwordx4 v6, s[20:23], s55 offen offset:2048 nt lds
  s_waitcnt vmcnt(23)
  buffer_load_dwordx4 v7, s[20:23], s55 offen offset:3072 nt lds
  s_add_u32 m0, s49, 4096
  s_waitcnt vmcnt(23)
  buffer_load_dwordx4 v8, s[20:23], s55 offen offset:0 nt lds
  ds_read_b128 v[116:119], v14 offset:16
  s_waitcnt vmcnt(23)
  buffer_load_dwordx4 v9, s[20:23], s55 offen offset:1024 nt lds
  s_waitcnt vmcnt(23)
  buffer_load_dwordx4 v10, s[20:23], s55 offen offset:2048 nt lds
  s_waitcnt vmcnt(23)
  buffer_load_dwordx4 v11, s[20:23], s55 offen offset:3072 nt lds
  v_add_u32 v104, -2, v105
  ds_write_b32 v14, v104
  s_add_u32 s50, s50, 0x2000
  s_add_u32 s49, s49, 0x2000
  s_cmp_lt_u32 s49, 90112
  s_cselect_b32 s49, s49, 0
  s_add_u32 s95, s95, 1
  s_cmp_lt_u32 s95, 256
  s_cbranch_scc1 L_ldtop
  s_branch L_ldtail
L_ldv7:
  s_add_u32 m0, s49, 0
  s_waitcnt vmcnt(24)
  buffer_load_dwordx4 v4, s[20:23], s55 offen offset:0 nt lds
  v_add_u32 v104, -3, v105
  ds_write_b32 v14, v104
  s_waitcnt vmcnt(24)
  buffer_load_dwordx4 v5, s[20:23], s55 offen offset:1024 nt lds
  s_waitcnt vmcnt(24)
  buffer_load_dwordx4 v6, s[20:23], s55 offen offset:2048 nt lds
  s_waitcnt vmcnt(24)
  buffer_load_dwordx4 v7, s[20:23], s55 offen offset:3072 nt lds
  s_add_u32 m0, s49, 4096
  s_waitcnt vmcnt(24)
  buffer_load_dwordx4 v8, s[20:23], s55 offen offset:0 nt lds
  ds_read_b128 v[116:119], v14 offset:16
  s_waitcnt vmcnt(24)
  buffer_load_dwordx4 v9, s[20:23], s55 offen offset:1024 nt lds
  s_waitcnt vmcnt(24)
  buffer_load_dwordx4 v10, s[20:23], s55 offen offset:2048 nt lds
  s_waitcnt vmcnt(24)
  buffer_load_dwordx4 v11, s[20:23], s55 offen offset:3072 nt lds
  s_add_u32 s50, s50, 0x2000
  s_add_u32 s49, s49, 0x2000
  s_cmp_lt_u32 s49, 90112
  s_cselect_b32 s49, s49, 0
  s_add_u32 s95, s95, 1
  s_cmp_lt_u32 s95, 256
  s_cbranch_scc1 L_ldtop
  s_branch L_ldtail
L_ldv8:
  s_add_u32 m0, s49, 0
  s_waitcnt vmcnt(25)
  buffer_load_dwordx4 v4, s[20:23], s55 offen offset:0 nt lds
  s_waitcnt vmcnt(25)
  buffer_load_dwordx4 v5, s[20:23], s55 offen offset:1024 nt lds
  v_add_u32 v104, -3, v105
  ds_write_b32 v14, v104
  s_waitcnt vmcnt(25)
  buffer_load_dwordx4 v6, s[20:23], s55 offen offset:2048 nt lds
  s_waitcnt vmcnt(25)
  buffer_load_dwordx4 v7, s[20:23], s55 offen offset:3072 nt lds
  s_add_u32 m0, s49, 4096
  s_waitcnt vmcnt(25)
  buffer_load_dwordx4 v8, s[20:23], s55 offen offset:0 nt lds
  ds_read_b128 v[116:119], v14 offset:16
  s_waitcnt vmcnt(25)
  buffer_load_dwordx4 v9, s[20:23], s55 offen offset:1024 nt lds
  s_waitcnt vmcnt(25)
  buffer_load_dwordx4 v10, s[20:23], s55 offen offset:2048 nt lds
  s_waitcnt vmcnt(25)
  buffer_load_dwordx4 v11, s[20:23], s55 offen offset:3072 nt lds
  s_add_u32 s50, s50, 0x2000
  s_add_u32 s49, s49, 0x2000
  s_cmp_lt_u32 s49, 90112
  s_cselect_b32 s49, s49, 0
  s_add_u32 s95, s95, 1
  s_cmp_lt_u32 s95, 256
  s_cbranch_scc1 L_ldtop
  s_branch L_ldtail
L_ldv9:
  s_add_u32 m0, s49, 0
  s_waitcnt vmcnt(26)
  buffer_load_dwordx4 v4, s[20:23], s55 offen offset:0 nt lds
  s_waitcnt vmcnt(26)
  buffer_load_dwordx4 v5, s[20:23], s55 offen offset:1024 nt lds
  s_waitcnt vmcnt(26)
  buffer_load_dwordx4 v6, s[20:23], s55 offen offset:2048 nt lds
  v_add_u32 v104, -3, v105
  ds_write_b32 v14, v104
  s_waitcnt vmcnt(26)
  buffer_load_dwordx4 v7, s[20:23], s55 offen offset:3072 nt lds
  s_add_u32 m0, s49, 4096
  s_waitcnt vmcnt(26)
  buffer_load_dwordx4 v8, s[20:23], s55 offen offset:0 nt lds
  ds_read_b128 v[116:119], v14 offset:16
  s_waitcnt vmcnt(26)
  buffer_load_dwordx4 v9, s[20:23], s55 offen offset:1024 nt lds
  s_waitcnt vmcnt(26)
  buffer_load_dwordx4 v10, s[20:23], s55 offen offset:2048 nt lds
  s_waitcnt vmcnt(26)
  buffer_load_dwordx4 v11, s[20:23], s55 offen offset:3072 nt lds
  s_add_u32 s50, s50, 0x2000
  s_add_u32 s49, s49, 0x2000
  s_cmp_lt_u32 s49, 90112
  s_cselect_b32 s49, s49, 0
  s_add_u32 s95, s95, 1
  s_cmp_lt_u32 s95, 256
  s_cbranch_scc1 L_ldtop
  s_branch L_ldtail
L_ldv10:
  s_add_u32 m0, s49, 0
  s_waitcnt vmcnt(27)
  buffer_load_dwordx4 v4, s[20:23], s55 offen offset:0 nt lds
  s_waitcnt vmcnt(27)
  buffer_load_dwordx4 v5, s[20:23], s55 offen offset:1024 nt lds
  s_waitcnt vmcnt(27)
  buffer_load_dwordx4 v6, s[20:23], s55 offen offset:2048 nt lds
  s_waitcnt vmcnt(27)
  buffer_load_dwordx4 v7, s[20:23], s55 offen offset:3072 nt lds
  v_add_u32 v104, -3, v105
  ds_write_b32 v14, v104
  s_add_u32 m0, s49, 4096
  s_waitcnt vmcnt(27)
  buffer_load_dwordx4 v8, s[20:23], s55 offen offset:0 nt lds
  ds_read_b128 v[116:119], v14 offset:16
  s_waitcnt vmcnt(27)
  buffer_load_dwordx4 v9, s[20:23], s55 offen offset:1024 nt lds
  s_waitcnt vmcnt(27)
  buffer_load_dwordx4 v10, s[20:23], s55 offen offset:2048 nt lds
  s_waitcnt vmcnt(27)
  buffer_load_dwordx4 v11, s[20:23], s55 offen offset:3072 nt lds
  s_add_u32 s50, s50, 0x2000
  s_add_u32 s49, s49, 0x2000
  s_cmp_lt_u32 s49, 90112
  s_cselect_b32 s49, s49, 0
  s_add_u32 s95, s95, 1
  s_cmp_lt_u32 s95, 256
  s_cbranch_scc1 L_ldtop
  s_branch L_ldtail
L_ldv11:
  s_add_u32 m0, s49, 0
  s_waitcnt vmcnt(29)
  buffer_load_dwordx4 v4, s[20:23], s55 offen offset:0 nt lds
  s_waitcnt vmcnt(29)
  buffer_load_dwordx4 v5, s[20:23], s55 offen offset:1024 nt lds
  s_waitcnt vmcnt(29)
  buffer_load_dwordx4 v6, s[20:23], s55 offen offset:2048 nt lds
  s_waitcnt vmcnt(29)
  buffer_load_dwordx4 v7, s[20:23], s55 offen offset:3072 nt lds
  s_add_u32 m0, s49, 4096
  s_waitcnt vmcnt(29)
  buffer_load_dwordx4 v8, s[20:23], s55 offen offset:0 nt lds
  ds_read_b128 v[116:119], v14 offset:16
  s_waitcnt vmcnt(29)
  buffer_load_dwordx4 v9, s[20:23], s55 offen offset:1024 nt lds
  v_add_u32 v104, -3, v105
  ds_write_b32 v14, v104
  s_waitcnt vmcnt(29)
  buffer_load_dwordx4 v10, s[20:23], s55 offen offset:2048 nt lds
  s_waitcnt vmcnt(29)
  buffer_load_dwordx4 v11, s[20:23], s55 offen offset:3072 nt lds
  s_add_u32 s50, s50, 0x2000
  s_add_u32 s49, s49, 0x2000
  s_cmp_lt_u32 s49, 90112
  s_cselect_b32 s49, s49, 0
  s_add_u32 s95, s95, 1
  s_cmp_lt_u32 s95, 256
  s_cbranch_scc1 L_ldtop
  s_branch L_ldtail
L_ldv12:
  s_add_u32 m0, s49, 0
  s_waitcnt vmcnt(31)
  buffer_load_dwordx4 v4, s[20:23], s55 offen offset:0 nt lds
  s_waitcnt vmcnt(31)
  buffer_load_dwordx4 v5, s[20:23], s55 offen offset:1024 nt lds
  s_waitcnt vmcnt(31)
  buffer_load_dwordx4 v6, s[20:23], s55 offen offset:2048 nt lds
  s_waitcnt vmcnt(31)
  buffer_load_dwordx4 v7, s[20:23], s55 offen offset:3072 nt lds
  s_add_u32 m0, s49, 4096
  s_waitcnt vmcnt(31)
  buffer_load_dwordx4 v8, s[20:23], s55 offen offset:0 nt lds
  ds_read_b128 v[116:119], v14 offset:16
  s_waitcnt vmcnt(31)
  buffer_load_dwordx4 v9, s[20:23], s55 offen offset:1024 nt lds
  s_waitcnt vmcnt(31)
  buffer_load_dwordx4 v10, s[20:23], s55 offen offset:2048 nt lds
  s_waitcnt vmcnt(31)
  buffer_load_dwordx4 v11, s[20:23], s55 offen offset:3072 nt lds
  v_add_u32 v104, -3, v105
  ds_write_b32 v14, v104
  s_add_u32 s50, s50, 0x2000
  s_add_u32 s49, s49, 0x2000
  s_cmp_lt_u32 s49, 90112
  s_cselect_b32 s49, s49, 0
  s_add_u32 s95, s95, 1
  s_cmp_lt_u32 s95, 256
  s_cbranch_scc1 L_ldtop
  s_branch L_ldtail
L_ldv13:
  s_add_u32 m0, s49, 0
  s_waitcnt vmcnt(35)
  buffer_load_dwordx4 v4, s[20:23], s55 offen offset:0 nt lds
  s_waitcnt vmcnt(35)
  buffer_load_dwordx4 v5, s[20:23], s55 offen offset:1024 nt lds
  s_waitcnt vmcnt(35)
  buffer_load_dwordx4 v6, s[20:23], s55 offen offset:2048 nt lds
  s_waitcnt vmcnt(35)
  buffer_load_dwordx4 v7, s[20:23], s55 offen offset:3072 nt lds
  v_add_u32 v104, -4, v105
  ds_write_b32 v14, v104
  s_add_u32 m0, s49, 4096
  s_waitcnt vmcnt(35)
  buffer_load_dwordx4 v8, s[20:23], s55 offen offset:0 nt lds
  ds_read_b128 v[116:119], v14 offset:16
  s_waitcnt vmcnt(35)
  buffer_load_dwordx4 v9, s[20:23], s55 offen offset:1024 nt lds
  s_waitcnt vmcnt(35)
  buffer_load_dwordx4 v10, s[20:23], s55 offen offset:2048 nt lds
  s_waitcnt vmcnt(35)
  buffer_load_dwordx4 v11, s[20:23], s55 offen offset:3072 nt lds
  s_add_u32 s50, s50, 0x2000
  s_add_u32 s49, s49, 0x2000
  s_cmp_lt_u32 s49, 90112
  s_cselect_b32 s49, s49, 0
  s_add_u32 s95, s95, 1
  s_cmp_lt_u32 s95, 256
  s_cbranch_scc1 L_ldtop
L_ldtail:
  s_waitcnt vmcnt(32)
  v_mov_b32 v104, 252
  ds_write_b32 v14, v104
  s_waitcnt vmcnt(24)
  v_mov_b32 v105, 253
  ds_write_b32 v14, v105
  s_waitcnt vmcnt(16)
  v_mov_b32 v104, 254
  ds_write_b32 v14, v104
  s_waitcnt vmcnt(8)
  v_mov_b32 v105, 255
  ds_write_b32 v14, v105
  s_waitcnt vmcnt(0) lgkmcnt(0)
  s_barrier
  s_endpgm
L_ldslow:
  s_sleep 1
  ds_read_b128 v[116:119], v14 offset:16
  s_branch L_ldchk
L_consumer:
  s_cmp_eq_u32 s48, 3
  s_cbranch_scc1 L_control
  v_lshlrev_b32 v97, 4, v100
  v_lshl_add_u32 v102, v101, 8, v97
  s_lshl_b32 s55, s3, 12
  s_mov_b32 s30, 0x1000
  s_mov_b32 s31, 0x20000
  s_sub_u32 s57, s48, 1
  s_waitcnt lgkmcnt(0)
  s_add_u32 s28, s4, s55
  s_addc_u32 s29, s5, 0
  buffer_load_dwordx4 a[0:3], v102, s[28:31], 0 offen offset:0 nt
  buffer_load_dwordx4 a[4:7], v102, s[28:31], 0 offen offset:64 nt
  buffer_load_dwordx4 a[8:11], v102, s[28:31], 0 offen offset:128 nt
  buffer_load_dwordx4 a[12:15], v102, s[28:31], 0 offen offset:192 nt
  s_add_u32 s44, s16, s55
  s_addc_u32 s45, s17, 0
  s_mov_b32 s46, 0x1000
  s_mov_b32 s47, 0x20000
  s_add_u32 s32, s10, s55
  s_addc_u32 s33, s11, 0
  s_mov_b32 s34, 0x1000
  s_mov_b32 s35, 0x20000
  s_add_u32 s36, s12, s55
  s_addc_u32 s37, s13, 0
  s_mov_b32 s38, 0x1000
  s_mov_b32 s39, 0x20000
  s_lshr_b32 s55, s3, 5
  s_lshl_b32 s55, s55, 9
  s_add_u32 s40, s14, s55
  s_addc_u32 s41, s15, 0
  s_mov_b32 s42, 0x200
  s_mov_b32 s43, 0x20000
  s_cmp_lg_u32 s57, 0
  s_cbranch_scc1 L_c1init
  buffer_load_dwordx4 v[16:19], v102, s[32:35], 0 offen offset:0 nt
  buffer_load_dwordx4 v[20:23], v102, s[32:35], 0 offen offset:64 nt
  buffer_load_dwordx4 v[24:27], v102, s[32:35], 0 offen offset:128 nt
  buffer_load_dwordx4 v[28:31], v102, s[32:35], 0 offen offset:192 nt
  v_lshlrev_b32 v97, 3, v100
  v_lshl_add_u32 v97, v101, 5, v97
  buffer_load_dwordx2 v[106:107], v97, s[40:43], 0 offen nt
  s_mov_b32 m0, 90112
  s_nop 0
  buffer_load_dwordx4 v2, s[36:39], 0 offen offset:0 nt lds
  buffer_load_dwordx4 v3, s[36:39], 0 offen offset:1024 nt lds
  buffer_load_dwordx4 v2, s[36:39], 0 offen offset:2048 nt lds
  buffer_load_dwordx4 v3, s[36:39], 0 offen offset:3072 nt lds
  s_branch L_notree0
L_c1init:
L_notree0:
  s_barrier
  v_and_b32 v97, 7, v101
  v_lshlrev_b32 v97, 1, v97
  v_xor_b32 v97, v97, v100
  v_lshlrev_b32 v97, 4, v97
  v_lshl_add_u32 v12, v101, 8, v97
  v_lshrrev_b32 v97, 2, v101
  v_lshl_add_u32 v97, v100, 2, v97
  v_and_b32 v98, 7, v97
  v_lshlrev_b32 v98, 5, v98
  v_lshl_add_u32 v98, v97, 8, v98
  v_and_b32 v99, 3, v101
  v_lshl_add_u32 v13, v99, 3, v98
  v_mov_b32 v48, 0
  v_mov_b32 v49, 0
  v_mov_b32 v50, 0
  v_mov_b32 v51, 0
  v_mov_b32 v52, 0
  v_mov_b32 v53, 0
  v_mov_b32 v54, 0
  v_mov_b32 v55, 0
  v_mov_b32 v56, 0
  v_mov_b32 v57, 0
  v_mov_b32 v58, 0
  v_mov_b32 v59, 0
  v_mov_b32 v60, 0
  v_mov_b32 v61, 0
  v_mov_b32 v62, 0
  v_mov_b32 v63, 0
  v_mov_b32 v64, 0
  v_mov_b32 v65, 0
  v_mov_b32 v66, 0
  v_mov_b32 v67, 0
  v_mov_b32 v68, 0
  v_mov_b32 v69, 0
  v_mov_b32 v70, 0
  v_mov_b32 v71, 0
  v_mov_b32 v72, 0
  v_mov_b32 v73, 0
  v_mov_b32 v74, 0
  v_mov_b32 v75, 0
  v_mov_b32 v76, 0
  v_mov_b32 v77, 0
  v_mov_b32 v78, 0
  v_mov_b32 v79, 0
  v_mov_b32 v92, 0xff7fffff
  v_mov_b32 v96, 0xff7fffff
  v_mov_b32 v93, 0
  s_mov_b32 s53, 0x3e0293ee
  s_mov_b32 s56, 0xd028965f
  s_lshl_b32 s49, s57, 13
  s_lshl_b32 s55, s57, 2
  v_add_u32 v110, s55, v14
  s_mul_i32 s50, s57, 30720
  s_add_u32 s50, s50, 90112
  s_mov_b32 s58, 0
  s_mov_b32 s96, 0
  s_add_u32 s59, s57, 1
  s_mov_b32 s97, 1
  s_waitcnt vmcnt(0)
  s_cmp_lg_u32 s57, 0
  s_cbranch_scc1 L_notree1
  v_add_u32 v4, 90112, v13
  v_xor_b32 v5, 32, v4
  v_xor_b32 v6, 64, v4
  v_xor_b32 v7, 96, v4
  v_xor_b32 v8, 128, v4
  v_xor_b32 v9, 160, v4
  v_xor_b32 v10, 192, v4
  v_xor_b32 v11, 224, v4
  ds_read_b64_tr_b16 v[32:33], v4
  ds_read_b64_tr_b16 v[34:35], v5
  ds_read_b64_tr_b16 v[36:37], v6
  ds_read_b64_tr_b16 v[38:39], v7
  ds_read_b64_tr_b16 v[40:41], v8
  ds_read_b64_tr_b16 v[42:43], v9
  ds_read_b64_tr_b16 v[44:45], v10
  ds_read_b64_tr_b16 v[46:47], v11
  v_mfma_f32_16x16x32_bf16 v[80:83], v[16:19], a[0:3], 0
  v_mfma_f32_16x16x32_bf16 v[80:83], v[20:23], a[4:7], v[80:83]
  v_mfma_f32_16x16x32_bf16 v[80:83], v[24:27], a[8:11], v[80:83]
  v_mfma_f32_16x16x32_bf16 v[80:83], v[28:31], a[12:15], v[80:83]
  v_lshlrev_b32 v84, 16, v106
  v_and_b32 v85, 0xffff0000, v106
  v_lshlrev_b32 v86, 16, v107
  v_and_b32 v87, 0xffff0000, v107
  v_sub_f32 v84, 1.0, v84
  v_sub_f32 v85, 1.0, v85
  v_sub_f32 v86, 1.0, v86
  v_sub_f32 v87, 1.0, v87
  s_nop 7
  v_fma_f32 v80, v84, s56, v80
  v_fma_f32 v81, v85, s56, v81
  v_fma_f32 v82, v86, s56, v82
  v_fma_f32 v83, v87, s56, v83
  v_max3_f32 v92, v80, v81, v82
  v_max_f32 v92, v92, v83
  v_mov_b32 v97, v92
  s_nop 1
  v_permlane16_swap_b32 v92, v97
  s_nop 1
  v_max_f32 v92, v92, v97
  v_mov_b32 v97, v92
  s_nop 1
  v_permlane32_swap_b32 v92, v97
  s_nop 1
  v_max_f32 v92, v92, v97
  v_mul_f32 v96, s53, v92
  v_fma_f32 v80, v80, s53, -v96
  v_fma_f32 v81, v81, s53, -v96
  v_fma_f32 v82, v82, s53, -v96
  v_fma_f32 v83, v83, s53, -v96
  v_exp_f32 v80, v80
  v_exp_f32 v81, v81
  v_exp_f32 v82, v82
  v_exp_f32 v83, v83
  s_nop 0
  v_add_f32 v93, v80, v81
  v_add_f32 v93, v93, v82
  v_add_f32 v93, v93, v83
  v_cvt_pk_bf16_f32 v88, v80, v81
  v_cvt_pk_bf16_f32 v89, v82, v83
  s_waitcnt lgkmcnt(0)
  s_nop 1
  v_mfma_f32_16x16x16_bf16 v[48:51], v[32:33], v[88:89], v[48:51]
  v_mfma_f32_16x16x16_bf16 v[52:55], v[34:35], v[88:89], v[52:55]
  v_mfma_f32_16x16x16_bf16 v[56:59], v[36:37], v[88:89], v[56:59]
  v_mfma_f32_16x16x16_bf16 v[60:63], v[38:39], v[88:89], v[60:63]
  v_mfma_f32_16x16x16_bf16 v[64:67], v[40:41], v[88:89], v[64:67]
  v_mfma_f32_16x16x16_bf16 v[68:71], v[42:43], v[88:89], v[68:71]
  v_mfma_f32_16x16x16_bf16 v[72:75], v[44:45], v[88:89], v[72:75]
  v_mfma_f32_16x16x16_bf16 v[76:79], v[46:47], v[88:89], v[76:79]
L_notree1:
L_phase:
  v_lshl_add_u32 v111, v1, 4, s50
  s_lshl_b32 s55, s57, 12
  s_add_u32 s55, s55, 151552
  v_lshl_add_u32 v112, v101, 2, s55
  s_mov_b32 s52, 0
L_kloop:
  v_add_u32 v4, s49, v12
  v_xor_b32 v5, 64, v4
  v_xor_b32 v6, 128, v4
  v_xor_b32 v7, 192, v4
  s_add_u32 s49, s49, 0x4000
  s_sub_u32 s55, s49, 90112
  s_cmp_lt_u32 s49, 90112
  s_cselect_b32 s49, s49, s55
  v_mov_b32 v104, s59
  s_cmp_ge_i32 s58, s59
  s_cbranch_scc1 L_goK
L_pollK:
  ds_read_b32 v15, v14
  s_waitcnt lgkmcnt(0)
  v_readfirstlane_b32 s58, v15
  s_cmp_ge_i32 s58, s59
  s_cbranch_scc1 L_goK
  s_sleep 1
  s_branch L_pollK
L_goK:
  ds_read_b128 v[16:19], v4 offset:0
  ds_read_b128 v[32:35], v4 offset:4096
  ds_read_b128 v[20:23], v5 offset:0
  ds_read_b128 v[36:39], v5 offset:4096
  ds_read_b128 v[24:27], v6 offset:0
  ds_read_b128 v[40:43], v6 offset:4096
  ds_read_b128 v[28:31], v7 offset:0
  ds_read_b128 v[44:47], v7 offset:4096
  s_waitcnt lgkmcnt(6)
  v_mfma_f32_16x16x32_bf16 v[80:83], v[16:19], a[0:3], 0
  v_mfma_f32_16x16x32_bf16 v[84:87], v[32:35], a[0:3], 0
  s_waitcnt lgkmcnt(4)
  v_mfma_f32_16x16x32_bf16 v[80:83], v[20:23], a[4:7], v[80:83]
  v_mfma_f32_16x16x32_bf16 v[84:87], v[36:39], a[4:7], v[84:87]
  s_waitcnt lgkmcnt(2)
  v_mfma_f32_16x16x32_bf16 v[80:83], v[24:27], a[8:11], v[80:83]
  v_mfma_f32_16x16x32_bf16 v[84:87], v[40:43], a[8:11], v[84:87]
  s_waitcnt lgkmcnt(0)
  v_mfma_f32_16x16x32_bf16 v[80:83], v[28:31], a[12:15], v[80:83]
  v_mfma_f32_16x16x32_bf16 v[84:87], v[44:47], a[12:15], v[84:87]
  ds_write_b32 v110, v104 offset:16
  s_nop 7
  v_max3_f32 v94, v80, v81, v92
  v_max3_f32 v94, v82, v83, v94
  v_max3_f32 v94, v84, v85, v94
  v_max3_f32 v94, v86, v87, v94
  v_mov_b32 v97, v94
  s_nop 1
  v_permlane16_swap_b32 v94, v97
  s_nop 1
  v_max_f32 v94, v94, v97
  v_mov_b32 v97, v94
  s_nop 1
  v_permlane32_swap_b32 v94, v97
  s_nop 1
  v_max_f32 v94, v94, v97
  v_mov_b32 v95, v96
  v_mul_f32 v96, s53, v94
  v_sub_f32 v95, v95, v96
  v_fma_f32 v80, v80, s53, -v96
  v_fma_f32 v81, v81, s53, -v96
  v_fma_f32 v82, v82, s53, -v96
  v_fma_f32 v83, v83, s53, -v96
  v_fma_f32 v84, v84, s53, -v96
  v_fma_f32 v85, v85, s53, -v96
  v_fma_f32 v86, v86, s53, -v96
  v_fma_f32 v87, v87, s53, -v96
  v_exp_f32 v95, v95
  v_exp_f32 v80, v80
  v_exp_f32 v81, v81
  v_exp_f32 v82, v82
  v_exp_f32 v83, v83
  v_exp_f32 v84, v84
  v_exp_f32 v85, v85
  v_exp_f32 v86, v86
  v_exp_f32 v87, v87
  v_mov_b32 v92, v94
  ds_write_b32 v112, v95
  v_fma_f32 v93, v93, v95, v80
  v_cvt_pk_bf16_f32 v88, v80, v81
  v_cvt_pk_bf16_f32 v89, v82, v83
  v_cvt_pk_bf16_f32 v90, v84, v85
  v_cvt_pk_bf16_f32 v91, v86, v87
  v_add_f32 v93, v93, v81
  v_add_f32 v93, v93, v82
  v_add_f32 v93, v93, v83
  v_add_f32 v93, v93, v84
  v_add_f32 v93, v93, v85
  v_add_f32 v93, v93, v86
  v_add_f32 v93, v93, v87
  v_add_u32 v112, 64, v112
  s_cmp_lt_u32 s52, 34
  s_cbranch_scc0 L_kst
  s_lshl_b32 s55, s52, 2
  s_set_gpr_idx_on s55, gpr_idx(DST)
  s_nop 0
  v_mov_b32 v120, v88
  v_mov_b32 v121, v89
  v_mov_b32 v122, v90
  v_mov_b32 v123, v91
  s_set_gpr_idx_off
  s_branch L_kst2
L_kst:
  ds_write_b128 v111, v[88:91]
  v_add_u32 v111, 1024, v111
L_kst2:
  s_add_u32 s59, s59, 2
  s_add_u32 s97, s97, 1
  s_add_u32 s52, s52, 1
  s_cmp_lt_u32 s52, 64
  s_cbranch_scc1 L_kloop
  s_cmp_lt_u32 s97, 64
  s_cbranch_scc1 L_noml
  v_mov_b32 v97, v93
  s_nop 1
  v_permlane16_swap_b32 v93, v97
  s_nop 1
  v_add_f32 v93, v93, v97
  v_mov_b32 v97, v93
  s_nop 1
  v_permlane32_swap_b32 v93, v97
  s_nop 1
  v_add_f32 v93, v93, v97
  s_lshl_b32 s55, s57, 7
  s_add_u32 s55, s55, 159808
  v_lshl_add_u32 v97, v101, 3, s55
  ds_write_b64 v97, v[92:93]
  v_mov_b32 v98, 1
  ds_write_b32 v110, v98 offset:32
L_noml:
  v_lshl_add_u32 v111, v1, 4, s50
  s_lshl_b32 s55, s57, 12
  s_add_u32 s55, s55, 151552
  v_lshl_add_u32 v112, v101, 2, s55
  s_mov_b32 s52, 0
L_vloop:
  ds_read_b32 v95, v112
  s_cmp_lt_u32 s52, 34
  s_cbranch_scc0 L_vld
  s_lshl_b32 s55, s52, 2
  s_set_gpr_idx_on s55, gpr_idx(SRC0)
  s_nop 0
  v_mov_b32 v88, v120
  v_mov_b32 v89, v121
  v_mov_b32 v90, v122
  v_mov_b32 v91, v123
  s_set_gpr_idx_off
  s_branch L_vld2
L_vld:
  ds_read_b128 v[88:91], v111
  v_add_u32 v111, 1024, v111
L_vld2:
  v_add_u32 v4, s49, v13
  v_xor_b32 v5, 32, v4
  v_xor_b32 v6, 64, v4
  v_xor_b32 v7, 96, v4
  v_xor_b32 v8, 128, v4
  v_xor_b32 v9, 160, v4
  v_xor_b32 v10, 192, v4
  v_xor_b32 v11, 224, v4
  s_add_u32 s49, s49, 0x4000
  s_sub_u32 s55, s49, 90112
  s_cmp_lt_u32 s49, 90112
  s_cselect_b32 s49, s49, s55
  v_mov_b32 v104, s59
  v_add_u32 v112, 64, v112
  s_waitcnt lgkmcnt(0)
  v_mul_f32 v48, v95, v48
  v_mul_f32 v49, v95, v49
  v_mul_f32 v50, v95, v50
  v_mul_f32 v51, v95, v51
  v_mul_f32 v52, v95, v52
  v_mul_f32 v53, v95, v53
  v_mul_f32 v54, v95, v54
  v_mul_f32 v55, v95, v55
  v_mul_f32 v56, v95, v56
  v_mul_f32 v57, v95, v57
  v_mul_f32 v58, v95, v58
  v_mul_f32 v59, v95, v59
  v_mul_f32 v60, v95, v60
  v_mul_f32 v61, v95, v61
  v_mul_f32 v62, v95, v62
  v_mul_f32 v63, v95, v63
  v_mul_f32 v64, v95, v64
  v_mul_f32 v65, v95, v65
  v_mul_f32 v66, v95, v66
  v_mul_f32 v67, v95, v67
  v_mul_f32 v68, v95, v68
  v_mul_f32 v69, v95, v69
  v_mul_f32 v70, v95, v70
  v_mul_f32 v71, v95, v71
  v_mul_f32 v72, v95, v72
  v_mul_f32 v73, v95, v73
  v_mul_f32 v74, v95, v74
  v_mul_f32 v75, v95, v75
  v_mul_f32 v76, v95, v76
  v_mul_f32 v77, v95, v77
  v_mul_f32 v78, v95, v78
  v_mul_f32 v79, v95, v79
  s_cmp_eq_u32 s59, 256
  s_cbranch_scc1 L_fin1
  s_cmp_ge_i32 s58, s59
  s_cbranch_scc1 L_goV
L_pollV:
  ds_read_b32 v15, v14
  s_waitcnt lgkmcnt(0)
  v_readfirstlane_b32 s58, v15
  s_cmp_ge_i32 s58, s59
  s_cbranch_scc1 L_goV
  s_sleep 1
  s_branch L_pollV
L_goV:
  ds_read_b64_tr_b16 v[16:17], v4 offset:0
  ds_read_b64_tr_b16 v[18:19], v4 offset:4096
  ds_read_b64_tr_b16 v[20:21], v5 offset:0
  ds_read_b64_tr_b16 v[22:23], v5 offset:4096
  ds_read_b64_tr_b16 v[24:25], v6 offset:0
  ds_read_b64_tr_b16 v[26:27], v6 offset:4096
  ds_read_b64_tr_b16 v[28:29], v7 offset:0
  ds_read_b64_tr_b16 v[30:31], v7 offset:4096
  ds_read_b64_tr_b16 v[32:33], v8 offset:0
  ds_read_b64_tr_b16 v[34:35], v8 offset:4096
  ds_read_b64_tr_b16 v[36:37], v9 offset:0
  ds_read_b64_tr_b16 v[38:39], v9 offset:4096
  ds_read_b64_tr_b16 v[40:41], v10 offset:0
  ds_read_b64_tr_b16 v[42:43], v10 offset:4096
  ds_read_b64_tr_b16 v[44:45], v11 offset:0
  ds_read_b64_tr_b16 v[46:47], v11 offset:4096
  s_waitcnt lgkmcnt(14)
  v_mfma_f32_16x16x32_bf16 v[48:51], v[16:19], v[88:91], v[48:51]
  s_waitcnt lgkmcnt(12)
  v_mfma_f32_16x16x32_bf16 v[52:55], v[20:23], v[88:91], v[52:55]
  s_waitcnt lgkmcnt(10)
  v_mfma_f32_16x16x32_bf16 v[56:59], v[24:27], v[88:91], v[56:59]
  s_waitcnt lgkmcnt(8)
  v_mfma_f32_16x16x32_bf16 v[60:63], v[28:31], v[88:91], v[60:63]
  s_waitcnt lgkmcnt(6)
  v_mfma_f32_16x16x32_bf16 v[64:67], v[32:35], v[88:91], v[64:67]
  s_waitcnt lgkmcnt(4)
  v_mfma_f32_16x16x32_bf16 v[68:71], v[36:39], v[88:91], v[68:71]
  s_waitcnt lgkmcnt(2)
  v_mfma_f32_16x16x32_bf16 v[72:75], v[40:43], v[88:91], v[72:75]
  s_waitcnt lgkmcnt(0)
  v_mfma_f32_16x16x32_bf16 v[76:79], v[44:47], v[88:91], v[76:79]
  ds_write_b32 v110, v104 offset:16
  s_cmp_lg_u32 s97, 120
  s_cbranch_scc1 L_nof
  v_xor_b32 v98, 4, v110
  s_xor_b32 s55, s57, 1
  s_lshl_b32 s55, s55, 7
  s_add_u32 s55, s55, 159808
  v_lshl_add_u32 v97, v101, 3, s55
L_mlp:
  ds_read_b32 v15, v98 offset:32
  ds_read_b64 v[80:81], v97
  s_waitcnt lgkmcnt(0)
  v_readfirstlane_b32 s55, v15
  s_cmp_eq_u32 s55, 0
  s_cbranch_scc1 L_mlp
  v_mul_f32 v80, s53, v80
  v_max_f32 v94, v96, v80
  v_sub_f32 v108, v96, v94
  v_sub_f32 v109, v80, v94
  v_exp_f32 v108, v108
  v_exp_f32 v109, v109
  s_nop 0
  v_mul_f32 v99, v108, v93
  v_fma_f32 v99, v109, v81, v99
  v_rcp_f32 v99, v99
  s_nop 0
  v_mul_f32 v108, v108, v99
  v_mul_f32 v109, v109, v99
  v_lshl_add_u32 v82, v1, 4, s50
  s_xor_b32 s55, s57, 1
  s_mul_i32 s55, s55, 30720
  s_add_u32 s55, s55, 90112
  v_lshl_add_u32 v83, v1, 4, s55
  v_and_b32 v97, 1, v100
  v_lshlrev_b32 v97, 5, v97
  v_lshrrev_b32 v98, 1, v100
  v_lshl_add_u32 v97, v98, 4, v97
  v_lshl_add_u32 v102, v101, 8, v97
  s_lshl_b32 s55, s57, 7
  v_add_u32 v102, s55, v102
L_nof:
  s_add_u32 s59, s59, 2
  s_add_u32 s97, s97, 1
  s_add_u32 s52, s52, 1
  s_cmp_lt_u32 s52, 64
  s_cbranch_scc1 L_vloop
  s_cmp_le_u32 s97, 128
  s_cbranch_scc1 L_phase
  ds_read_b128 v[88:91], v83 offset:29696
  ds_write_b128 v82, v[64:67] offset:0
  ds_write_b128 v82, v[68:71] offset:1024
  ds_write_b128 v82, v[72:75] offset:2048
  ds_write_b128 v82, v[76:79] offset:3072
  v_add_u32 v4, 16384, v13
  v_xor_b32 v5, 32, v4
  v_xor_b32 v6, 64, v4
  v_xor_b32 v7, 96, v4
  v_mul_f32 v136, v108, v48
  v_mul_f32 v137, v108, v49
  v_mul_f32 v138, v108, v50
  v_mul_f32 v139, v108, v51
  v_mul_f32 v140, v108, v52
  v_mul_f32 v141, v108, v53
  v_mul_f32 v142, v108, v54
  v_mul_f32 v143, v108, v55
  v_mul_f32 v144, v108, v56
  v_mul_f32 v145, v108, v57
  v_mul_f32 v146, v108, v58
  v_mul_f32 v147, v108, v59
  v_mul_f32 v148, v108, v60
  v_mul_f32 v149, v108, v61
  v_mul_f32 v150, v108, v62
  v_mul_f32 v151, v108, v63
  s_waitcnt lgkmcnt(0)
  s_barrier
  ds_read_b128 v[152:155], v83 offset:0
  ds_read_b64_tr_b16 v[16:17], v4 offset:0
  ds_read_b64_tr_b16 v[18:19], v4 offset:4096
  ds_read_b128 v[156:159], v83 offset:1024
  ds_read_b64_tr_b16 v[20:21], v5 offset:0
  ds_read_b64_tr_b16 v[22:23], v5 offset:4096
  ds_read_b128 v[160:163], v83 offset:2048
  ds_read_b64_tr_b16 v[24:25], v6 offset:0
  ds_read_b64_tr_b16 v[26:27], v6 offset:4096
  ds_read_b128 v[164:167], v83 offset:3072
  ds_read_b64_tr_b16 v[28:29], v7 offset:0
  ds_read_b64_tr_b16 v[30:31], v7 offset:4096
  s_waitcnt lgkmcnt(9)
  v_mfma_f32_16x16x32_bf16 v[152:155], v[16:19], v[88:91], v[152:155]
  s_waitcnt lgkmcnt(6)
  v_mfma_f32_16x16x32_bf16 v[156:159], v[20:23], v[88:91], v[156:159]
  s_waitcnt lgkmcnt(3)
  v_mfma_f32_16x16x32_bf16 v[160:163], v[24:27], v[88:91], v[160:163]
  s_waitcnt lgkmcnt(0)
  v_mfma_f32_16x16x32_bf16 v[164:167], v[28:31], v[88:91], v[164:167]
  s_nop 1
  v_fma_f32 v136, v109, v152, v136
  v_fma_f32 v137, v109, v153, v137
  v_fma_f32 v138, v109, v154, v138
  v_fma_f32 v139, v109, v155, v139
  v_cvt_pk_bf16_f32 v120, v136, v137
  v_cvt_pk_bf16_f32 v121, v138, v139
  v_fma_f32 v140, v109, v156, v140
  v_fma_f32 v141, v109, v157, v141
  v_fma_f32 v142, v109, v158, v142
  v_fma_f32 v143, v109, v159, v143
  v_cvt_pk_bf16_f32 v122, v140, v141
  v_cvt_pk_bf16_f32 v123, v142, v143
  s_nop 1
  v_permlane16_swap_b32 v120, v122
  v_permlane16_swap_b32 v121, v123
  buffer_store_dwordx4 v[120:123], v102, s[44:47], 0 offen offset:0
  v_fma_f32 v144, v109, v160, v144
  v_fma_f32 v145, v109, v161, v145
  v_fma_f32 v146, v109, v162, v146
  v_fma_f32 v147, v109, v163, v147
  v_cvt_pk_bf16_f32 v124, v144, v145
  v_cvt_pk_bf16_f32 v125, v146, v147
  v_fma_f32 v148, v109, v164, v148
  v_fma_f32 v149, v109, v165, v149
  v_fma_f32 v150, v109, v166, v150
  v_fma_f32 v151, v109, v167, v151
  v_cvt_pk_bf16_f32 v126, v148, v149
  v_cvt_pk_bf16_f32 v127, v150, v151
  s_nop 1
  v_permlane16_swap_b32 v124, v126
  v_permlane16_swap_b32 v125, v127
  buffer_store_dwordx4 v[124:127], v102, s[44:47], 0 offen offset:64
  s_branch L_end
L_fin1:
  ds_write_b128 v82, v[48:51] offset:0
  ds_write_b128 v82, v[52:55] offset:1024
  ds_write_b128 v82, v[56:59] offset:2048
  ds_write_b128 v82, v[60:63] offset:3072
  s_waitcnt lgkmcnt(0)
  s_barrier
  ds_read_b64_tr_b16 v[32:33], v8 offset:0
  ds_read_b64_tr_b16 v[34:35], v8 offset:4096
  ds_read_b64_tr_b16 v[36:37], v9 offset:0
  ds_read_b64_tr_b16 v[38:39], v9 offset:4096
  ds_read_b64_tr_b16 v[40:41], v10 offset:0
  ds_read_b64_tr_b16 v[42:43], v10 offset:4096
  ds_read_b64_tr_b16 v[44:45], v11 offset:0
  ds_read_b64_tr_b16 v[46:47], v11 offset:4096
  ds_read_b128 v[152:155], v83 offset:0
  ds_read_b128 v[156:159], v83 offset:1024
  ds_read_b128 v[160:163], v83 offset:2048
  ds_read_b128 v[164:167], v83 offset:3072
  s_waitcnt lgkmcnt(10)
  v_mfma_f32_16x16x32_bf16 v[64:67], v[32:35], v[88:91], v[64:67]
  s_waitcnt lgkmcnt(8)
  v_mfma_f32_16x16x32_bf16 v[68:71], v[36:39], v[88:91], v[68:71]
  s_waitcnt lgkmcnt(6)
  v_mfma_f32_16x16x32_bf16 v[72:75], v[40:43], v[88:91], v[72:75]
  s_waitcnt lgkmcnt(4)
  v_mfma_f32_16x16x32_bf16 v[76:79], v[44:47], v[88:91], v[76:79]
  s_waitcnt lgkmcnt(0)
  v_mul_f32 v152, v109, v152
  v_mul_f32 v153, v109, v153
  v_mul_f32 v154, v109, v154
  v_mul_f32 v155, v109, v155
  v_mul_f32 v156, v109, v156
  v_mul_f32 v157, v109, v157
  v_mul_f32 v158, v109, v158
  v_mul_f32 v159, v109, v159
  v_mul_f32 v160, v109, v160
  v_mul_f32 v161, v109, v161
  v_mul_f32 v162, v109, v162
  v_mul_f32 v163, v109, v163
  v_mul_f32 v164, v109, v164
  v_mul_f32 v165, v109, v165
  v_mul_f32 v166, v109, v166
  v_mul_f32 v167, v109, v167
  v_fma_f32 v152, v108, v64, v152
  v_fma_f32 v153, v108, v65, v153
  v_fma_f32 v154, v108, v66, v154
  v_fma_f32 v155, v108, v67, v155
  v_cvt_pk_bf16_f32 v120, v152, v153
  v_cvt_pk_bf16_f32 v121, v154, v155
  v_fma_f32 v156, v108, v68, v156
  v_fma_f32 v157, v108, v69, v157
  v_fma_f32 v158, v108, v70, v158
  v_fma_f32 v159, v108, v71, v159
  v_cvt_pk_bf16_f32 v122, v156, v157
  v_cvt_pk_bf16_f32 v123, v158, v159
  s_nop 1
  v_permlane16_swap_b32 v120, v122
  v_permlane16_swap_b32 v121, v123
  buffer_store_dwordx4 v[120:123], v102, s[44:47], 0 offen offset:0
  v_fma_f32 v160, v108, v72, v160
  v_fma_f32 v161, v108, v73, v161
  v_fma_f32 v162, v108, v74, v162
  v_fma_f32 v163, v108, v75, v163
  v_cvt_pk_bf16_f32 v124, v160, v161
  v_cvt_pk_bf16_f32 v125, v162, v163
  v_fma_f32 v164, v108, v76, v164
  v_fma_f32 v165, v108, v77, v165
  v_fma_f32 v166, v108, v78, v166
  v_fma_f32 v167, v108, v79, v167
  v_cvt_pk_bf16_f32 v126, v164, v165
  v_cvt_pk_bf16_f32 v127, v166, v167
  s_nop 1
  v_permlane16_swap_b32 v124, v126
  v_permlane16_swap_b32 v125, v127
  buffer_store_dwordx4 v[124:127], v102, s[44:47], 0 offen offset:64
L_end:
  s_endpgm
L_control:
  s_barrier
  s_and_b32 s57, s2, 7
  s_mul_i32 s57, s57, 5
  s_lshr_b32 s49, s2, 3
  s_mov_b32 s56, 0
  s_waitcnt lgkmcnt(0)
  s_add_u32 s88, s86, 0x2000000
  s_addc_u32 s89, s87, 0
  s_and_b32 s92, s49, 3
  s_cmp_eq_u32 s92, 0
  s_cselect_b32 s92, 1, 0
  s_or_b32 s56, s56, s92
  s_bfe_u32 s55, s49, 196610
  s_lshl_b32 s55, s55, 8
  s_add_u32 s20, s55, 0
  s_add_u32 s49, s49, s57
  s_load_dword s62, s[88:89], s20 glc
  s_and_b32 s92, s49, 3
  s_cmp_eq_u32 s92, 1
  s_cselect_b32 s92, 2, 0
  s_or_b32 s56, s56, s92
  s_bfe_u32 s55, s49, 196610
  s_lshl_b32 s55, s55, 8
  s_add_u32 s21, s55, 2048
  s_add_u32 s49, s49, s57
  s_load_dword s63, s[88:89], s21 glc
  s_and_b32 s92, s49, 3
  s_cmp_eq_u32 s92, 2
  s_cselect_b32 s92, 4, 0
  s_or_b32 s56, s56, s92
  s_bfe_u32 s55, s49, 196610
  s_lshl_b32 s55, s55, 8
  s_add_u32 s22, s55, 4096
  s_add_u32 s49, s49, s57
  s_load_dword s64, s[88:89], s22 glc
  s_and_b32 s92, s49, 3
  s_cmp_eq_u32 s92, 3
  s_cselect_b32 s92, 8, 0
  s_or_b32 s56, s56, s92
  s_bfe_u32 s55, s49, 196610
  s_lshl_b32 s55, s55, 8
  s_add_u32 s23, s55, 6144
  s_add_u32 s49, s49, s57
  s_load_dword s65, s[88:89], s23 glc
  s_and_b32 s92, s49, 3
  s_cmp_eq_u32 s92, 0
  s_cselect_b32 s92, 16, 0
  s_or_b32 s56, s56, s92
  s_bfe_u32 s55, s49, 196610
  s_lshl_b32 s55, s55, 8
  s_add_u32 s24, s55, 8192
  s_add_u32 s49, s49, s57
  s_load_dword s66, s[88:89], s24 glc
  s_and_b32 s92, s49, 3
  s_cmp_eq_u32 s92, 1
  s_cselect_b32 s92, 32, 0
  s_or_b32 s56, s56, s92
  s_bfe_u32 s55, s49, 196610
  s_lshl_b32 s55, s55, 8
  s_add_u32 s25, s55, 10240
  s_add_u32 s49, s49, s57
  s_load_dword s67, s[88:89], s25 glc
  s_and_b32 s92, s49, 3
  s_cmp_eq_u32 s92, 2
  s_cselect_b32 s92, 64, 0
  s_or_b32 s56, s56, s92
  s_bfe_u32 s55, s49, 196610
  s_lshl_b32 s55, s55, 8
  s_add_u32 s26, s55, 12288
  s_add_u32 s49, s49, s57
  s_load_dword s68, s[88:89], s26 glc
  s_and_b32 s92, s49, 3
  s_cmp_eq_u32 s92, 3
  s_cselect_b32 s92, 128, 0
  s_or_b32 s56, s56, s92
  s_bfe_u32 s55, s49, 196610
  s_lshl_b32 s55, s55, 8
  s_add_u32 s27, s55, 14336
  s_add_u32 s49, s49, s57
  s_load_dword s69, s[88:89], s27 glc
  s_and_b32 s92, s49, 3
  s_cmp_eq_u32 s92, 0
  s_cselect_b32 s92, 256, 0
  s_or_b32 s56, s56, s92
  s_bfe_u32 s55, s49, 196610
  s_lshl_b32 s55, s55, 8
  s_add_u32 s28, s55, 16384
  s_add_u32 s49, s49, s57
  s_load_dword s70, s[88:89], s28 glc
  s_and_b32 s92, s49, 3
  s_cmp_eq_u32 s92, 1
  s_cselect_b32 s92, 512, 0
  s_or_b32 s56, s56, s92
  s_bfe_u32 s55, s49, 196610
  s_lshl_b32 s55, s55, 8
  s_add_u32 s29, s55, 18432
  s_add_u32 s49, s49, s57
  s_load_dword s71, s[88:89], s29 glc
  s_and_b32 s92, s49, 3
  s_cmp_eq_u32 s92, 2
  s_cselect_b32 s92, 1024, 0
  s_or_b32 s56, s56, s92
  s_bfe_u32 s55, s49, 196610
  s_lshl_b32 s55, s55, 8
  s_add_u32 s30, s55, 20480
  s_add_u32 s49, s49, s57
  s_load_dword s72, s[88:89], s30 glc
  s_and_b32 s92, s49, 3
  s_cmp_eq_u32 s92, 3
  s_cselect_b32 s92, 2048, 0
  s_or_b32 s56, s56, s92
  s_bfe_u32 s55, s49, 196610
  s_lshl_b32 s55, s55, 8
  s_add_u32 s31, s55, 22528
  s_add_u32 s49, s49, s57
  s_load_dword s73, s[88:89], s31 glc
  s_and_b32 s92, s49, 3
  s_cmp_eq_u32 s92, 0
  s_cselect_b32 s92, 4096, 0
  s_or_b32 s56, s56, s92
  s_bfe_u32 s55, s49, 196610
  s_lshl_b32 s55, s55, 8
  s_add_u32 s32, s55, 24576
  s_add_u32 s49, s49, s57
  s_load_dword s74, s[88:89], s32 glc
  s_and_b32 s92, s49, 3
  s_cmp_eq_u32 s92, 1
  s_cselect_b32 s92, 8192, 0
  s_or_b32 s56, s56, s92
  s_bfe_u32 s55, s49, 196610
  s_lshl_b32 s55, s55, 8
  s_add_u32 s33, s55, 26624
  s_add_u32 s49, s49, s57
  s_load_dword s75, s[88:89], s33 glc
  s_and_b32 s92, s49, 3
  s_cmp_eq_u32 s92, 2
  s_cselect_b32 s92, 16384, 0
  s_or_b32 s56, s56, s92
  s_bfe_u32 s55, s49, 196610
  s_lshl_b32 s55, s55, 8
  s_add_u32 s34, s55, 28672
  s_add_u32 s49, s49, s57
  s_load_dword s76, s[88:89], s34 glc
  s_and_b32 s92, s49, 3
  s_cmp_eq_u32 s92, 3
  s_cselect_b32 s92, 32768, 0
  s_or_b32 s56, s56, s92
  s_bfe_u32 s55, s49, 196610
  s_lshl_b32 s55, s55, 8
  s_add_u32 s35, s55, 30720
  s_add_u32 s49, s49, s57
  s_load_dword s77, s[88:89], s35 glc
  s_mov_b32 s80, 0x38281808
  s_mov_b32 s81, 0x78685848
  s_mov_b32 s82, 0xc8b4a08c
  s_mov_b32 s83, 0xf6eee4d8
  s_mov_b32 s52, 0
  s_mov_b32 s96, 0
  s_waitcnt lgkmcnt(0)
L_ck:
  s_mov_b32 m0, s52
  s_nop 0
  s_movrels_b32 s78, s20
  s_movrels_b32 s79, s62
  s_and_b32 s59, s80, 0xff
  s_lshr_b64 s[80:81], s[80:81], 8
  s_cmp_eq_u32 s52, 7
  s_cselect_b64 s[80:81], s[82:83], s[80:81]
L_ckp:
  ds_read_b32 v15, v14
  s_waitcnt lgkmcnt(0)
  v_readfirstlane_b32 s58, v15
  s_cmp_ge_i32 s58, s59
  s_cbranch_scc1 L_ckg
  s_sleep 2
  s_branch L_ckp
L_ckg:
  s_bitcmp1_b32 s56, s52
  s_cbranch_scc1 L_cks
  s_load_dword s55, s[88:89], s78 glc
  s_waitcnt lgkmcnt(0)
  s_sub_u32 s55, s55, s79
  s_cmp_ge_u32 s55, 5
  s_subb_u32 s55, s55, 0
  s_branch L_ckr
L_cks:
  s_mov_b32 s55, 1
  s_atomic_add s55, s[88:89], s78 glc
  s_waitcnt lgkmcnt(0)
  s_sub_u32 s55, s55, s79
L_ckr:
  s_mov_b32 s94, 18
  s_cmp_ge_u32 s55, 1
  s_addc_u32 s94, s94, 0
  s_cmp_ge_u32 s55, 2
  s_addc_u32 s94, s94, 0
  s_cmp_ge_u32 s55, 4
  s_addc_u32 s94, s94, 0
  s_cmp_ge_u32 s55, 5
  s_addc_u32 s94, s94, 0
  s_cmp_ge_u32 s55, 6
  s_addc_u32 s94, s94, 0
  s_cmp_ge_u32 s55, 7
  s_addc_u32 s94, s94, 0
  s_sub_i32 s93, s96, 3
  s_max_i32 s93, s93, 0
  s_cmp_le_u32 s55, 6
  s_cselect_b32 s96, s93, s96
  s_add_u32 s94, s94, s96
  s_add_u32 s93, s96, 3
  s_min_u32 s93, s93, 12
  s_cmp_ge_u32 s55, 7
  s_cselect_b32 s96, s93, s96
  v_mov_b32 v97, s94
  ds_write_b32 v14, v97 offset:24
  s_add_u32 s52, s52, 1
  s_cmp_lt_u32 s52, 16
  s_cbranch_scc1 L_ck
  s_waitcnt lgkmcnt(0)
  s_endpgm
L_codeend:
.section .rodata,"a"
.p2align 6
.amdhsa_kernel standalone__tree_speculative_verify_tree_attention_over_candidate_token_tree__sampling_kernel
  .amdhsa_next_free_vgpr 272
  .amdhsa_next_free_sgpr 100
  .amdhsa_accum_offset 256
  .amdhsa_group_segment_fixed_size 0
  .amdhsa_kernarg_size 72
  .amdhsa_user_sgpr_count 2
  .amdhsa_user_sgpr_kernarg_segment_ptr 1
  .amdhsa_system_sgpr_workgroup_id_x 1
.end_amdhsa_kernel
```
